```python
import torch

def _softmax(x, axis=-1):
    return torch.softmax(x, dim=axis)
def _gelu(x):
    return torch.nn.functional.gelu(x, approximate="tanh")
def _silu(x):
    return torch.nn.functional.silu(x)
def _sigmoid(x):
    return torch.sigmoid(x)
def _layernorm(x, axis=-1, eps=1e-5):
    m = x.mean(dim=axis, keepdim=True)
    v = x.var(dim=axis, keepdim=True, unbiased=False)
    return (x - m) / torch.sqrt(v + eps)
def _scatter_add(tgt, idx, src, axis=0):
    return tgt.clone().index_add_(axis, idx, src)
def _segment_sum(src, seg, n):
    out = torch.zeros((n,) + src.shape[1:], dtype=src.dtype)
    return out.index_add_(0, seg, src)
def _pad(x, pw):
    flat = tuple(v for pair in reversed(pw) for v in pair)
    return torch.nn.functional.pad(x, flat)

kernel_name = 'standalone__paged_block_table_kv_pagedattention__decode'

def setup_inputs():

    _w = (lambda a: (lambda t: t.to(torch.bfloat16) if t.is_floating_point() else t)(torch.as_tensor(a)))
    B, Hq, Hkv, Sq, Skv, D = 1, 16, 8, 1, 65536, 256
    bs = 16
    nbps = max(1, Skv // bs)
    num_phys = B * nbps + 4
    bt = torch.randperm(num_phys)[: B * nbps].reshape(B, nbps).to(torch.int64)
    cl = (nbps * bs - (torch.arange(1, B + 1, dtype=torch.int64) * 2654435761) % max(1, nbps * bs // 2)).to(torch.int64)
    return {
        "q": _w((lambda *s: torch.randn(*s, dtype=torch.bfloat16) * 0.8)(B, Hq, Sq, D)),
        "k_cache": _w((lambda *s: torch.randn(*s, dtype=torch.bfloat16) * 0.8)(num_phys, bs, Hkv, D)),
        "v_cache": _w((lambda *s: torch.randn(*s, dtype=torch.bfloat16) * 0.05)(num_phys, bs, Hkv, D)),
        "block_table": _w(bt),
        "context_lens": _w(cl),
    }

def reference(q, k_cache, v_cache, block_table, context_lens):
    B, Hq, Sq, D = q.shape
    bs = k_cache.shape[1]
    Hkv = k_cache.shape[2]
    nbps = block_table.shape[1]
    Skv = nbps * bs
    bt = block_table.reshape(-1)
    k = (lambda x, *d: x.permute(*d))(k_cache[bt].reshape(B, Skv, Hkv, D), 0, 2, 1, 3)
    v = (lambda x, *d: x.permute(*d))(v_cache[bt].reshape(B, Skv, Hkv, D), 0, 2, 1, 3)
    g = Hq // Hkv
    qg = q.reshape(B, Hkv, g, Sq, D)
    scores = torch.einsum("bhgqd,bhkd->bhgqk", qg, k) * (D ** -0.5)
    pos = torch.arange(Skv)
    msk = pos[None, :] < context_lens[:, None]
    scores = torch.where(msk[:, None, None, None, :], scores, -1e9)
    p = _softmax(scores, axis=-1)
    out = torch.einsum("bhgqk,bhkd->bhgqd", p, v)
    return out.reshape(B, Hq, Sq, D)
```

```asm
; @launch grid=(256,1,1) block=(256,1,1) lds=157440
.amdgcn_target "amdgcn-amd-amdhsa--gfx950"
.text
.globl standalone__paged_block_table_kv_pagedattention__decode_kernel
.p2align 8
.type standalone__paged_block_table_kv_pagedattention__decode_kernel,@function
standalone__paged_block_table_kv_pagedattention__decode_kernel:
    s_cmp_ge_u32 s2, 256
    s_cbranch_scc1 L_exit
    s_load_dwordx16 s[4:19], s[0:1], 0
    v_lshrrev_b32 v4, 6, v0
    v_and_b32 v1, 63, v0
    v_readfirstlane_b32 s54, v4
    s_lshr_b32 s55, s2, 5
    s_and_b32 s56, s2, 31
    s_cmp_lg_u32 s54, 0
    s_cbranch_scc1 L_other
    v_lshlrev_b32 v6, 7, v1
    s_lshl_b32 s59, s56, 2
    v_add_u32 v6, s59, v6
    s_lshl_b32 s58, s55, 9
    v_lshrrev_b32 v4, 5, v1
    v_and_b32 v5, 31, v1
    v_xor_b32 v5, v5, v4
    v_lshl_add_u32 v8, v5, 4, s58
    v_lshl_add_u32 v8, v4, 12, v8
    v_add_u32 v7, 0x2000, v6
    v_add_u32 v9, 7136, v8
    v_add_u32 v10, 14272, v8
    v_add_u32 v11, 21408, v8
    v_add_u32 v12, 32768, v8
    v_add_u32 v13, 39904, v8
    v_add_u32 v14, 47040, v8
    v_add_u32 v15, 54176, v8
    s_mov_b32 s46, 16384
    s_mov_b32 s47, 0x20000
    s_mov_b32 s22, 0x10040000
    s_mov_b32 s23, 0x20000
    v_lshlrev_b32 v18, 4, v1
    v_lshlrev_b32 v5, 2, v1
    v_mov_b32 v22, 0
    v_mov_b32 v21, 0
    v_mov_b32 v16, 0
    v_mov_b32 v17, 0
    v_mov_b32 v24, 0
    v_mov_b32 v25, 0x7fffffff
    v_mov_b32 v26, -1
    v_mov_b32 v27, 0
    s_mov_b32 s91, 0
    s_mov_b32 s60, 22272
    s_waitcnt lgkmcnt(0)
    s_load_dword s48, s[12:13], 0
    s_load_dword s94, s[10:11], s59 offset:0
    s_load_dword s95, s[10:11], s59 offset:128
    s_load_dword s96, s[10:11], s59 offset:256
    s_mov_b32 s44, s10
    s_and_b32 s45, s11, 0xffff
    buffer_load_dword v2, v6, s[44:47], 0 offen
    buffer_load_dword v3, v7, s[44:47], 0 offen
    s_mov_b32 s24, s6
    s_and_b32 s25, s7, 0xffff
    s_mov_b32 s26, s8
    s_and_b32 s27, s9, 0xffff
    ds_write_b128 v18, v[24:27] offset:0
    s_waitcnt lgkmcnt(0)
    s_min_i32 s58, s48, 0x10000
    s_add_i32 s49, s58, 15
    s_lshr_b32 s49, s49, 4
    s_cmp_lt_i32 s48, 1
    s_cselect_b32 s49, 0x1000, s49
    s_cselect_b32 s48, 0, s58
    s_lshr_b32 s50, s49, 5
    s_sub_i32 s50, s50, 4
    s_max_i32 s50, s50, 0
    s_lshl_b32 s92, s50, 1
    s_and_b32 s58, s50, 15
    s_lshl_b32 s58, s58, 2
    v_mov_b32 v19, s58
    s_cmp_ge_u32 s50, 3
    s_cbranch_scc0 L_ld_nopre
    s_mov_b64 s[20:21], s[24:25]
    s_lshl_b32 s53, s94, 16
    s_mov_b32 m0, 22272
    s_nop 0
    buffer_load_dwordx4 v8, s[20:23], s53 offen offset:0 nt lds
    buffer_load_dwordx4 v9, s[20:23], s53 offen offset:1056 nt lds
    buffer_load_dwordx4 v10, s[20:23], s53 offen offset:2112 nt lds
    buffer_load_dwordx4 v11, s[20:23], s53 offen offset:3168 nt lds
    s_mov_b32 m0, 26496
    s_nop 0
    buffer_load_dwordx4 v12, s[20:23], s53 offen offset:0 nt lds
    buffer_load_dwordx4 v13, s[20:23], s53 offen offset:1056 nt lds
    buffer_load_dwordx4 v14, s[20:23], s53 offen offset:2112 nt lds
    buffer_load_dwordx4 v15, s[20:23], s53 offen offset:3168 nt lds
    s_lshl_b32 s53, s95, 16
    s_mov_b32 m0, 30720
    s_nop 0
    buffer_load_dwordx4 v8, s[20:23], s53 offen offset:0 nt lds
    buffer_load_dwordx4 v9, s[20:23], s53 offen offset:1056 nt lds
    buffer_load_dwordx4 v10, s[20:23], s53 offen offset:2112 nt lds
    buffer_load_dwordx4 v11, s[20:23], s53 offen offset:3168 nt lds
    s_mov_b32 m0, 34944
    s_nop 0
    buffer_load_dwordx4 v12, s[20:23], s53 offen offset:0 nt lds
    buffer_load_dwordx4 v13, s[20:23], s53 offen offset:1056 nt lds
    buffer_load_dwordx4 v14, s[20:23], s53 offen offset:2112 nt lds
    buffer_load_dwordx4 v15, s[20:23], s53 offen offset:3168 nt lds
    s_lshl_b32 s53, s96, 16
    s_mov_b32 m0, 39168
    s_nop 0
    buffer_load_dwordx4 v8, s[20:23], s53 offen offset:0 nt lds
    buffer_load_dwordx4 v9, s[20:23], s53 offen offset:1056 nt lds
    buffer_load_dwordx4 v10, s[20:23], s53 offen offset:2112 nt lds
    buffer_load_dwordx4 v11, s[20:23], s53 offen offset:3168 nt lds
    s_mov_b32 m0, 43392
    s_nop 0
    buffer_load_dwordx4 v12, s[20:23], s53 offen offset:0 nt lds
    buffer_load_dwordx4 v13, s[20:23], s53 offen offset:1056 nt lds
    s_barrier
    s_waitcnt vmcnt(21)
    buffer_load_dwordx4 v14, s[20:23], s53 offen offset:2112 nt lds
    s_waitcnt vmcnt(21)
    buffer_load_dwordx4 v15, s[20:23], s53 offen offset:3168 nt lds
    s_mov_b32 s91, 3
    v_mov_b32 v21, 3
    s_mov_b32 s60, 47616
    s_waitcnt vmcnt(24)
    s_branch L_ld_bar2
    L_ld_nopre:
    s_waitcnt vmcnt(0)
    L_ld_bar:
    s_barrier
    L_ld_bar2:
    ds_read_b32 v20, v19 offset:1536
L_ld_loop:
    s_cmp_eq_u32 s91, 4
    s_cbranch_scc1 L_ld_sorted
    L_ld_cont:
    s_cmp_ge_u32 s91, s92
    s_cbranch_scc1 L_ld_dyn
    s_sub_u32 s51, s91, s50
    s_cselect_b32 s51, s91, s51
    s_cselect_b64 s[20:21], s[24:25], s[26:27]
    v_readlane_b32 s53, v2, s51
    v_readlane_b32 s59, v3, s51
    s_cmp_ge_u32 s51, 64
    s_cselect_b32 s53, s59, s53
    s_lshl_b32 s53, s53, 16
    L_ld_chk:
    s_waitcnt lgkmcnt(0)
    v_readfirstlane_b32 s58, v16
    v_readfirstlane_b32 s61, v17
    s_mov_b32 m0, s60
    s_min_u32 s58, s58, s61
    s_add_u32 s58, s58, 16
    s_cmp_gt_u32 s58, s91
    s_cbranch_scc0 L_ld_rechk
    s_waitcnt vmcnt(21)
    buffer_load_dwordx4 v8, s[20:23], s53 offen offset:0 nt lds
    s_waitcnt vmcnt(21)
    buffer_load_dwordx4 v9, s[20:23], s53 offen offset:1056 nt lds
    s_waitcnt vmcnt(21)
    buffer_load_dwordx4 v10, s[20:23], s53 offen offset:2112 nt lds
    s_waitcnt vmcnt(21)
    buffer_load_dwordx4 v11, s[20:23], s53 offen offset:3168 nt lds
    ds_read_b64 v[16:17], v22 offset:1024
    ds_read_b32 v20, v19 offset:1536
    s_add_u32 m0, s60, 4224
    s_waitcnt vmcnt(21)
    buffer_load_dwordx4 v12, s[20:23], s53 offen offset:0 nt lds
    s_waitcnt vmcnt(21)
    buffer_load_dwordx4 v13, s[20:23], s53 offen offset:1056 nt lds
    v_add_u32 v4, -2, v21
    v_max_i32 v24, v24, v4
    ds_write_b128 v18, v[24:27] offset:0
    s_waitcnt vmcnt(21)
    buffer_load_dwordx4 v14, s[20:23], s53 offen offset:2112 nt lds
    s_waitcnt vmcnt(21)
    buffer_load_dwordx4 v15, s[20:23], s53 offen offset:3168 nt lds
    v_add_u32 v21, 1, v21
    s_add_u32 s60, s60, 8448
    s_cmp_ge_u32 s60, 157440
    s_cselect_b32 s60, 22272, s60
    s_add_u32 s91, s91, 1
    s_branch L_ld_loop
    L_ld_rechk:
    ds_read_b64 v[16:17], v22 offset:1024
    s_branch L_ld_chk
    L_ld_sorted:
    ds_read_b32 v4, v22 offset:1664
    ds_read_b32 v2, v5 offset:2816
    ds_read_b32 v3, v5 offset:3072
    s_waitcnt lgkmcnt(0)
    v_readfirstlane_b32 s58, v4
    s_cmp_eq_u32 s58, 0
    s_cbranch_scc0 L_ld_cont
    s_branch L_ld_sorted
    L_ld_dyn:
    s_bitcmp1_b32 s91, 0
    s_cselect_b64 s[20:21], s[26:27], s[24:25]
    s_cbranch_scc1 L_ld_chk
    s_lshr_b32 s51, s91, 1
    s_branch L_ld_q
    L_ld_requ:
    s_getreg_b32 s58, hwreg(HW_REG_IB_STS)
    ds_read_b32 v20, v19 offset:1536
    s_bfe_u32 s59, s58, 0x20016
    s_and_b32 s58, s58, 15
    s_lshl4_add_u32 s58, s59, s58
    s_add_u32 s58, s58, 7
    s_lshr_b32 s58, s58, 3
    v_subrev_u32 v4, s58, v21
    v_max_i32 v24, v24, v4
    ds_write_b128 v18, v[24:27] offset:0
    L_ld_q:
    s_add_u32 s59, s51, 1
    s_waitcnt lgkmcnt(0)
    v_readfirstlane_b32 s87, v20
    s_and_b32 s58, s87, 0x3fff
    s_cmp_lg_u32 s58, s59
    s_cbranch_scc1 L_ld_requ
    v_add_u32 v19, 4, v19
    v_and_b32 v19, 63, v19
    s_and_b32 s53, s87, 0xffff0000
    s_bitcmp0_b32 s87, 15
    s_cbranch_scc1 L_ld_nolast
    v_mov_b32 v26, s51
    L_ld_nolast:
    s_bitcmp0_b32 s87, 14
    s_cbranch_scc1 L_ld_chk
    v_mov_b32 v25, s51
    v_add_u32 v4, -2, v21
    v_max_i32 v24, v24, v4
    s_waitcnt vmcnt(16)
    ds_write_b128 v18, v[24:27] offset:0
    v_add_u32 v4, -1, v21
    v_max_i32 v24, v24, v4
    s_waitcnt vmcnt(8)
    ds_write_b128 v18, v[24:27] offset:0
    v_add_u32 v4, 0, v21
    v_max_i32 v24, v24, v4
    s_waitcnt vmcnt(0)
    ds_write_b128 v18, v[24:27] offset:0
    s_branch L_end
    L_other:
    s_cmp_eq_u32 s54, 3
    s_cbranch_scc1 L_sched
    L_cons:
    s_sub_u32 s54, s54, 1
    v_and_b32 v21, 15, v0
    v_bfe_u32 v22, v0, 4, 2
    v_and_b32 v16, 1, v0
    v_lshlrev_b32 v17, 9, v16
    v_lshl_add_u32 v17, v22, 4, v17
    s_lshl_b32 s58, s55, 10
    s_waitcnt lgkmcnt(0)
    s_load_dword s48, s[12:13], 0
    s_mov_b32 s28, s4
    s_and_b32 s29, s5, 0xffff
    s_mov_b32 s30, 0x2000
    s_mov_b32 s31, 0x20000
    buffer_load_dwordx4 v[48:51], v17, s[28:31], s58 offen offset:0
    buffer_load_dwordx4 v[52:55], v17, s[28:31], s58 offen offset:64
    buffer_load_dwordx4 v[56:59], v17, s[28:31], s58 offen offset:128
    buffer_load_dwordx4 v[60:63], v17, s[28:31], s58 offen offset:192
    buffer_load_dwordx4 v[64:67], v17, s[28:31], s58 offen offset:256
    buffer_load_dwordx4 v[68:71], v17, s[28:31], s58 offen offset:320
    buffer_load_dwordx4 v[72:75], v17, s[28:31], s58 offen offset:384
    buffer_load_dwordx4 v[76:79], v17, s[28:31], s58 offen offset:448
    s_barrier
    s_mov_b32 s32, s18
    s_and_b32 s33, s19, 0xffff
    s_mov_b32 s34, 0x240000
    s_mov_b32 s35, 0x20000
    s_mov_b32 s36, s14
    s_and_b32 s37, s15, 0xffff
    s_mov_b32 s38, 0x2000
    s_mov_b32 s39, 0x20000
    s_lshl_b32 s63, s55, 16
    s_lshl_b32 s59, s56, 6
    s_add_u32 s63, s63, s59
    s_add_u32 s89, s63, 0x8000
    s_lshl_b32 s53, s2, 11
    s_and_b32 s88, s56, 3
    s_lshl_b32 s88, s88, 6
    s_bfe_u32 s59, s56, 0x20002
    s_lshl_b32 s59, s59, 2
    s_add_u32 s88, s88, s59
    s_lshr_b32 s59, s56, 4
    s_lshl_b32 s59, s59, 8
    s_add_u32 s88, s88, s59
    s_lshl_b32 s59, s55, 10
    s_add_u32 s88, s88, s59
    s_mov_b32 s94, 0x07060501
    s_mov_b32 s95, 0x07060502
    s_mov_b32 s96, 0x07060503
    s_mov_b32 s97, 0x0c04000c
    v_lshrrev_b32 v154, 2, v1
    v_lshlrev_b32 v154, 11, v154
    v_and_b32 v18, 3, v1
    v_lshl_add_u32 v154, v18, 4, v154
    v_bfe_u32 v155, v1, 4, 1
    v_lshlrev_b32 v155, 9, v155
    v_lshl_add_u32 v155, v18, 4, v155
    v_lshrrev_b32 v18, 5, v1
    v_lshl_add_u32 v155, v18, 1, v155
    v_lshlrev_b32 v156, 4, v1
    v_lshlrev_b32 v157, 3, v1
    s_mov_b32 s57, 0x3db8aa3b
    v_lshrrev_b32 v2, 1, v21
    v_mul_u32_u24 v2, 1056, v2
    v_lshl_add_u32 v2, v16, 9, v2
    v_xor_b32 v18, v22, v16
    v_lshl_add_u32 v2, v18, 4, v2
    v_mul_u32_u24 v3, 2112, v22
    v_xor_b32 v18, 1, v21
    v_lshl_add_u32 v149, v18, 4, v3
    v_add_u32 v149, 512, v149
    v_lshl_add_u32 v3, v21, 4, v3
    v_lshlrev_b32 v151, 5, v22
    v_lshl_add_u32 v151, v16, 4, v151
    v_mov_b32 v6, 0
    s_lshl_b32 s58, s54, 2
    v_lshl_add_u32 v7, v1, 3, s58
    v_lshlrev_b32 v14, 2, v22
    v_bfe_u32 v18, v0, 1, 1
    v_lshlrev_b32 v18, 4, v18
    v_mov_b32 v19, 0xffff
    v_lshlrev_b32 v19, v18, v19
    v_bfe_u32 v18, v0, 2, 2
    v_cmp_eq_u32 vcc, 0, v18
    s_nop 1
    v_cndmask_b32 v8, 0, v19, vcc
    v_cmp_eq_u32 vcc, 1, v18
    s_nop 1
    v_cndmask_b32 v9, 0, v19, vcc
    v_cmp_eq_u32 vcc, 2, v18
    s_nop 1
    v_cndmask_b32 v10, 0, v19, vcc
    v_cmp_eq_u32 vcc, 3, v18
    s_nop 1
    v_cndmask_b32 v11, 0, v19, vcc
    v_mov_b32 v12, 0xff61b1e6
    v_mov_b32 v153, 0xff61b1e6
    v_mov_b32 v13, 0
    v_mov_b32 v24, 0
    v_mov_b32 v25, 0
    v_mov_b32 v26, 0
    v_mov_b32 v27, 0
    v_mov_b32 v28, 0
    v_mov_b32 v29, 0
    v_mov_b32 v30, 0
    v_mov_b32 v31, 0
    s_waitcnt lgkmcnt(0)
    s_min_i32 s58, s48, 0x10000
    s_add_i32 s49, s58, 15
    s_lshr_b32 s49, s49, 4
    s_cmp_lt_i32 s48, 1
    s_cselect_b32 s49, 0x1000, s49
    s_cselect_b32 s48, 0, s58
    s_cselect_b32 s85, 0, 16
    s_lshl_b32 s58, s49, 4
    s_sub_i32 s84, s48, s58
    s_add_i32 s84, s84, 16
    s_lshr_b32 s50, s49, 5
    s_sub_i32 s50, s50, 4
    s_max_i32 s50, s50, 0
    s_mov_b32 s51, s54
    s_mov_b32 s61, 0
    s_mov_b32 s82, 0x7fffffff
    s_mov_b32 s83, -1
    s_cmp_lt_u32 s51, s50
    s_cselect_b32 s87, 1, 3
    s_lshl_b32 s91, s51, 1
    s_cmp_lt_u32 s51, s50
    s_cselect_b32 s91, s51, s91
    s_waitcnt vmcnt(0)
    L_c_kloop:
    s_and_b32 s60, s91, 15
    s_mul_i32 s60, s60, 8448
    s_add_u32 s60, s60, 22272
    v_add_u32 v4, s60, v2
    L_c_pk:
    s_cmp_gt_i32 s61, s91
    s_cbranch_scc1 L_c_k
    s_cmp_ge_u32 s51, s82
    s_cbranch_scc1 L_c_done
    ds_read_b128 v[20:23], v6 offset:0
    s_waitcnt lgkmcnt(0)
    v_readfirstlane_b32 s61, v20
    v_readfirstlane_b32 s82, v21
    v_readfirstlane_b32 s83, v22
    s_branch L_c_pk
    L_c_k:
    ds_read_b128 v[80:83], v4 offset:0
    ds_read_b128 v[84:87], v4 offset:64
    ds_read_b128 v[88:91], v4 offset:128
    ds_read_b128 v[92:95], v4 offset:192
    ds_read_b128 v[96:99], v4 offset:256
    ds_read_b128 v[100:103], v4 offset:320
    ds_read_b128 v[104:107], v4 offset:384
    ds_read_b128 v[108:111], v4 offset:448
    s_cmp_eq_u32 s51, s83
    s_cselect_b32 s52, s84, s85
    s_lshl_b32 s58, s51, 7
    v_add_u32 v152, s58, v151
    s_add_u32 s59, s91, 2
    s_add_u32 s58, s50, s54
    s_cmp_lt_u32 s59, s50
    s_cselect_b32 s59, s59, s58
    s_add_u32 s91, s91, 1
    s_cmp_eq_u32 s87, 1
    s_cselect_b32 s91, s59, s91
    v_mov_b32 v148, s91
    s_waitcnt lgkmcnt(7)
    v_mfma_f32_16x16x32_bf16 v[16:19], v[80:83], v[48:51], 0
    s_waitcnt lgkmcnt(6)
    v_mfma_f32_16x16x32_bf16 v[16:19], v[84:87], v[52:55], v[16:19]
    s_waitcnt lgkmcnt(5)
    v_mfma_f32_16x16x32_bf16 v[16:19], v[88:91], v[56:59], v[16:19]
    s_waitcnt lgkmcnt(4)
    v_mfma_f32_16x16x32_bf16 v[16:19], v[92:95], v[60:63], v[16:19]
    s_waitcnt lgkmcnt(3)
    v_mfma_f32_16x16x32_bf16 v[16:19], v[96:99], v[64:67], v[16:19]
    s_waitcnt lgkmcnt(2)
    v_mfma_f32_16x16x32_bf16 v[16:19], v[100:103], v[68:71], v[16:19]
    s_waitcnt lgkmcnt(1)
    v_mfma_f32_16x16x32_bf16 v[16:19], v[104:107], v[72:75], v[16:19]
    s_waitcnt lgkmcnt(0)
    ds_write_b32 v7, v148 offset:1024
    v_mfma_f32_16x16x32_bf16 v[16:19], v[108:111], v[76:79], v[16:19]
    ds_read_b128 v[20:23], v6 offset:0
    s_and_b32 s60, s91, 15
    s_mul_i32 s60, s60, 8448
    s_add_u32 s60, s60, 22272
    v_add_u32 v5, s60, v3
    v_add_u32 v150, s60, v149
    s_cmp_ge_i32 s52, 16
    s_cbranch_scc1 L_nomask
    v_mov_b32 v144, 0xd0800000
    v_sub_u32 v145, s52, v14
    v_cmp_lt_i32 vcc, 0, v145
    s_nop 1
    v_cndmask_b32 v16, v144, v16, vcc
    v_cmp_lt_i32 vcc, 1, v145
    s_nop 1
    v_cndmask_b32 v17, v144, v17, vcc
    v_cmp_lt_i32 vcc, 2, v145
    s_nop 1
    v_cndmask_b32 v18, v144, v18, vcc
    v_cmp_lt_i32 vcc, 3, v145
    s_nop 1
    v_cndmask_b32 v19, v144, v19, vcc
    L_nomask:
    v_max3_f32 v153, v153, v16, v17
    v_max3_f32 v153, v153, v18, v19
    s_waitcnt lgkmcnt(0)
    v_readfirstlane_b32 s61, v20
    v_readfirstlane_b32 s82, v21
    v_readfirstlane_b32 s83, v22
    s_cmp_lg_u32 s87, 1
    s_cbranch_scc1 L_c_resc
    s_mov_b32 exec_lo, 0x00030003
    s_mov_b32 exec_hi, 0x00030003
    ds_write_b128 v152, v[16:19] offset:5888
    s_mov_b64 exec, -1
    s_add_u32 s51, s51, 2
    s_cmp_lt_u32 s51, s50
    s_cbranch_scc1 L_c_kloop
    s_mov_b32 s51, s54
    s_mov_b32 s87, 2
    L_c_resc:
    v_mov_b32 v20, v153
    s_nop 1
    v_permlane16_swap_b32 v153, v20
    v_max_f32 v153, v153, v20
    v_mov_b32 v20, v153
    s_nop 1
    v_permlane32_swap_b32 v153, v20
    v_max_f32 v153, v153, v20
    v_mul_f32 v20, s57, v153
    v_sub_f32 v15, v12, v20
    v_exp_f32 v15, v15
    v_mov_b32 v12, v20
    s_nop 0
    v_mul_f32 v13, v13, v15
    v_mul_f32_dpp v24, v15, v24 quad_perm:[0,0,2,2] row_mask:0xf bank_mask:0xf
    v_mul_f32_dpp v25, v15, v25 quad_perm:[1,1,3,3] row_mask:0xf bank_mask:0xf
    v_mul_f32_dpp v26, v15, v26 quad_perm:[0,0,2,2] row_mask:0xf bank_mask:0xf
    v_mul_f32_dpp v27, v15, v27 quad_perm:[1,1,3,3] row_mask:0xf bank_mask:0xf
    v_mul_f32_dpp v28, v15, v28 quad_perm:[0,0,2,2] row_mask:0xf bank_mask:0xf
    v_mul_f32_dpp v29, v15, v29 quad_perm:[1,1,3,3] row_mask:0xf bank_mask:0xf
    v_mul_f32_dpp v30, v15, v30 quad_perm:[0,0,2,2] row_mask:0xf bank_mask:0xf
    v_mul_f32_dpp v31, v15, v31 quad_perm:[1,1,3,3] row_mask:0xf bank_mask:0xf
    s_cmp_eq_u32 s87, 3
    s_cbranch_scc1 L_c_vs
    L_c_vloop:
    s_lshl_b32 s58, s51, 7
    v_add_u32 v152, s58, v151
    ds_read_b128 v[20:23], v6 offset:0
    ds_read_b128 v[16:19], v152 offset:5888
    s_and_b32 s60, s91, 15
    s_mul_i32 s60, s60, 8448
    s_add_u32 s60, s60, 22272
    v_add_u32 v5, s60, v3
    v_add_u32 v150, s60, v149
    s_waitcnt lgkmcnt(0)
    v_readfirstlane_b32 s61, v20
    v_readfirstlane_b32 s82, v21
    v_readfirstlane_b32 s83, v22
L_c_vs:
    s_mov_b32 s62, s91
    s_cmp_gt_i32 s61, s62
    s_cbranch_scc0 L_c_vlate
    ds_read_b128 v[112:115], v5 offset:0
    ds_read_b128 v[116:119], v5 offset:256
    ds_read_b128 v[120:123], v150 offset:0
    ds_read_b128 v[124:127], v150 offset:256
    ds_read_b128 v[128:131], v5 offset:1056
    ds_read_b128 v[132:135], v5 offset:1312
    ds_read_b128 v[136:139], v150 offset:1056
    ds_read_b128 v[140:143], v150 offset:1312
L_c_vlate:
    v_fma_f32 v16, v16, s57, -v12
    v_fma_f32 v17, v17, s57, -v12
    v_fma_f32 v18, v18, s57, -v12
    v_fma_f32 v19, v19, s57, -v12
    v_exp_f32 v16, v16
    v_exp_f32 v17, v17
    v_exp_f32 v18, v18
    v_exp_f32 v19, v19
    s_add_u32 s51, s51, 2
    s_add_u32 s91, s91, 2
    s_lshl_b32 s58, s51, 1
    s_cmp_lt_u32 s51, s50
    s_cselect_b32 s91, s91, s58
    s_cselect_b32 s87, 2, 3
    v_mov_b32 v148, s91
    v_cvt_pk_bf16_f32 v144, v16, v16
    v_and_b32 v32, v144, v8
    v_and_b32 v33, v144, v9
    v_and_b32 v34, v144, v10
    v_and_b32 v35, v144, v11
    s_cmp_gt_i32 s61, s62
    s_cbranch_scc1 L_c_v
    v_cvt_pk_bf16_f32 v145, v17, v17
    v_and_b32 v36, v145, v8
    v_and_b32 v37, v145, v9
    v_and_b32 v38, v145, v10
    v_and_b32 v39, v145, v11
    v_cvt_pk_bf16_f32 v146, v18, v18
    v_and_b32 v40, v146, v8
    v_and_b32 v41, v146, v9
    v_and_b32 v42, v146, v10
    v_and_b32 v43, v146, v11
    v_cvt_pk_bf16_f32 v147, v19, v19
    v_and_b32 v44, v147, v8
    v_and_b32 v45, v147, v9
    v_and_b32 v46, v147, v10
    v_and_b32 v47, v147, v11
    L_c_pv:
    ds_read_b128 v[20:23], v6 offset:0
    s_waitcnt lgkmcnt(0)
    v_readfirstlane_b32 s61, v20
    v_readfirstlane_b32 s82, v21
    v_readfirstlane_b32 s83, v22
    s_cmp_gt_i32 s61, s62
    s_cbranch_scc0 L_c_pv
    ds_read_b128 v[112:115], v5 offset:0
    ds_read_b128 v[116:119], v5 offset:256
    ds_read_b128 v[120:123], v150 offset:0
    ds_read_b128 v[124:127], v150 offset:256
    ds_read_b128 v[128:131], v5 offset:1056
    ds_read_b128 v[132:135], v5 offset:1312
    ds_read_b128 v[136:139], v150 offset:1056
    ds_read_b128 v[140:143], v150 offset:1312
L_c_v:
    s_waitcnt lgkmcnt(7)
    v_mfma_f32_16x16x32_bf16 v[24:27], v[32:35], v[112:115], v[24:27]
    v_cvt_pk_bf16_f32 v145, v17, v17
    v_and_b32 v36, v145, v8
    v_and_b32 v37, v145, v9
    v_and_b32 v38, v145, v10
    v_and_b32 v39, v145, v11
    s_waitcnt lgkmcnt(6)
    v_mfma_f32_16x16x32_bf16 v[28:31], v[32:35], v[116:119], v[28:31]
    s_waitcnt lgkmcnt(5)
    v_mfma_f32_16x16x32_bf16 v[24:27], v[36:39], v[120:123], v[24:27]
    v_cvt_pk_bf16_f32 v146, v18, v18
    v_and_b32 v40, v146, v8
    v_and_b32 v41, v146, v9
    v_and_b32 v42, v146, v10
    v_and_b32 v43, v146, v11
    s_waitcnt lgkmcnt(4)
    v_mfma_f32_16x16x32_bf16 v[28:31], v[36:39], v[124:127], v[28:31]
    s_waitcnt lgkmcnt(3)
    v_mfma_f32_16x16x32_bf16 v[24:27], v[40:43], v[128:131], v[24:27]
    v_cvt_pk_bf16_f32 v147, v19, v19
    v_and_b32 v44, v147, v8
    v_and_b32 v45, v147, v9
    v_and_b32 v46, v147, v10
    v_and_b32 v47, v147, v11
    s_waitcnt lgkmcnt(2)
    v_mfma_f32_16x16x32_bf16 v[28:31], v[40:43], v[132:135], v[28:31]
    s_waitcnt lgkmcnt(1)
    v_mfma_f32_16x16x32_bf16 v[24:27], v[44:47], v[136:139], v[24:27]
    s_waitcnt lgkmcnt(0)
    ds_write_b32 v7, v148 offset:1024
    v_mfma_f32_16x16x32_bf16 v[28:31], v[44:47], v[140:143], v[28:31]
    v_add_f32 v20, v16, v17
    v_add_f32 v21, v18, v19
    v_add_f32 v13, v13, v20
    v_add_f32 v13, v13, v21
    s_cmp_eq_u32 s87, 2
    s_cbranch_scc1 L_c_vloop
    s_branch L_c_kloop
    L_c_done:
    v_mov_b32 v21, v13
    s_add_u32 s58, s82, 1
    s_and_b32 s58, s58, 1
    v_permlane16_swap_b32 v13, v21
    v_add_f32 v13, v13, v21
    v_mov_b32 v21, v13
    s_mov_b32 vcc_lo, 0xaaaaaaaa
    s_mov_b32 vcc_hi, 0xaaaaaaaa
    v_permlane32_swap_b32 v13, v21
    v_add_f32 v13, v13, v21
    s_cmp_eq_u32 s58, s54
    s_cbranch_scc1 L_fin
    ds_write_b128 v156, v[24:27] offset:3328
    ds_write_b128 v156, v[28:31] offset:4352
    ds_write_b64 v157, v[12:13] offset:5376
    s_waitcnt lgkmcnt(0)
    s_barrier
    s_branch L_end
    L_fin:
    s_barrier
    ds_read_b64 v[32:33], v157 offset:5376
    ds_read_b128 v[80:83], v156 offset:3328
    ds_read_b128 v[84:87], v156 offset:4352
    s_mov_b32 s62, 0x40000
    s_mov_b64 s[4:5], -1
    s_mov_b64 s[6:7], -1
    s_waitcnt lgkmcnt(2)
    v_max_f32 v21, v12, v32
    v_sub_f32 v15, v12, v21
    v_sub_f32 v32, v32, v21
    v_exp_f32 v15, v15
    v_exp_f32 v32, v32
    s_nop 0
    v_mul_f32 v13, v13, v15
    v_fmac_f32 v13, v32, v33
    v_mul_f32_dpp v24, v15, v24 quad_perm:[0,0,2,2] row_mask:0xf bank_mask:0xf
    v_mul_f32_dpp v25, v15, v25 quad_perm:[1,1,3,3] row_mask:0xf bank_mask:0xf
    v_mul_f32_dpp v26, v15, v26 quad_perm:[0,0,2,2] row_mask:0xf bank_mask:0xf
    v_mul_f32_dpp v27, v15, v27 quad_perm:[1,1,3,3] row_mask:0xf bank_mask:0xf
    v_mul_f32_dpp v28, v15, v28 quad_perm:[0,0,2,2] row_mask:0xf bank_mask:0xf
    v_mul_f32_dpp v29, v15, v29 quad_perm:[1,1,3,3] row_mask:0xf bank_mask:0xf
    v_mul_f32_dpp v30, v15, v30 quad_perm:[0,0,2,2] row_mask:0xf bank_mask:0xf
    v_mul_f32_dpp v31, v15, v31 quad_perm:[1,1,3,3] row_mask:0xf bank_mask:0xf
    v_mov_b32_dpp v20, v13 quad_perm:[0,0,1,1] row_mask:0xf bank_mask:0xf
    v_cndmask_b32_dpp v20, v21, v20, vcc quad_perm:[0,0,1,1] row_mask:0xf bank_mask:0xf
    v_min_u32 v115, -2, v20
    v_min_u32 v119, -2, v20
    s_waitcnt lgkmcnt(1)
    v_fmac_f32_dpp v24, v32, v80 quad_perm:[0,0,2,2] row_mask:0xf bank_mask:0xf
    v_fmac_f32_dpp v25, v32, v81 quad_perm:[1,1,3,3] row_mask:0xf bank_mask:0xf
    v_fmac_f32_dpp v26, v32, v82 quad_perm:[0,0,2,2] row_mask:0xf bank_mask:0xf
    v_fmac_f32_dpp v27, v32, v83 quad_perm:[1,1,3,3] row_mask:0xf bank_mask:0xf
    v_perm_b32 v112, v24, v27, s94
    v_perm_b32 v113, v25, v27, s95
    v_perm_b32 v114, v26, v27, s96
    v_min_u32 v112, -2, v112
    v_min_u32 v113, -2, v113
    v_min_u32 v114, -2, v114
    buffer_store_dwordx4 v[112:115], v154, s[32:35], s63 offen sc1
    s_waitcnt lgkmcnt(0)
    v_fmac_f32_dpp v28, v32, v84 quad_perm:[0,0,2,2] row_mask:0xf bank_mask:0xf
    v_fmac_f32_dpp v29, v32, v85 quad_perm:[1,1,3,3] row_mask:0xf bank_mask:0xf
    v_fmac_f32_dpp v30, v32, v86 quad_perm:[0,0,2,2] row_mask:0xf bank_mask:0xf
    v_fmac_f32_dpp v31, v32, v87 quad_perm:[1,1,3,3] row_mask:0xf bank_mask:0xf
    v_perm_b32 v116, v28, v31, s94
    v_perm_b32 v117, v29, v31, s95
    v_perm_b32 v118, v30, v31, s96
    v_min_u32 v116, -2, v116
    v_min_u32 v117, -2, v117
    v_min_u32 v118, -2, v118
    buffer_store_dwordx4 v[116:119], v154, s[32:35], s89 offen sc1
L_poll:
    s_or_b64 exec, s[4:5], 1
    buffer_load_dwordx4 v[48:51], v156, s[32:35], s53 offen offset:0 sc1
    s_or_b64 exec, s[6:7], 1
    buffer_load_dwordx4 v[52:55], v156, s[32:35], s53 offen offset:1024 sc1
    s_mov_b64 exec, -1
    s_sub_u32 s62, s62, 1
    s_cselect_b64 vcc, 0, -1
    s_waitcnt vmcnt(1)
    v_max3_u32 v16, v48, v49, v50
    v_max_u32 v16, v16, v51
    v_cmp_eq_u32 s[4:5], -1, v16
    s_waitcnt vmcnt(0)
    v_max3_u32 v17, v52, v53, v54
    v_max_u32 v17, v17, v55
    v_cmp_eq_u32 s[6:7], -1, v17
    v_max_f32 v80, v51, v55
    s_or_b64 s[8:9], s[4:5], s[6:7]
    s_and_b64 s[8:9], s[8:9], vcc
    s_cbranch_scc1 L_poll
    v_max_f32_dpp v80, v80, v80 row_ror:4 row_mask:0xf bank_mask:0xf
    v_perm_b32 v84, v49, v48, s97
    v_perm_b32 v85, v53, v52, s97
    v_max_f32_dpp v80, v80, v80 row_ror:8 row_mask:0xf bank_mask:0xf
    v_mov_b32 v81, v80
    v_lshl_or_b32 v84, v50, 24, v84
    v_lshl_or_b32 v85, v54, 24, v85
    v_permlane16_swap_b32 v80, v81
    v_max_f32 v80, v80, v81
    v_mov_b32 v81, v80
    s_nop 1
    v_permlane32_swap_b32 v80, v81
    v_max_f32 v80, v80, v81
    v_sub_f32 v82, v51, v80
    v_sub_f32 v83, v55, v80
    v_exp_f32 v82, v82
    v_exp_f32 v83, v83
    s_nop 0
    v_mul_f32_dpp v86, v82, v51 quad_perm:[0,0,2,2] row_mask:0xf bank_mask:0xf
    v_mul_f32_dpp v88, v82, v48 quad_perm:[0,0,0,0] row_mask:0xf bank_mask:0xf
    v_mul_f32_dpp v89, v82, v49 quad_perm:[2,2,2,2] row_mask:0xf bank_mask:0xf
    v_mul_f32_dpp v90, v82, v50 quad_perm:[0,0,0,0] row_mask:0xf bank_mask:0xf
    v_mul_f32_dpp v91, v82, v84 quad_perm:[2,2,2,2] row_mask:0xf bank_mask:0xf
    v_fmac_f32_dpp v86, v83, v55 quad_perm:[0,0,2,2] row_mask:0xf bank_mask:0xf
    v_fmac_f32_dpp v88, v83, v52 quad_perm:[0,0,0,0] row_mask:0xf bank_mask:0xf
    v_fmac_f32_dpp v89, v83, v53 quad_perm:[2,2,2,2] row_mask:0xf bank_mask:0xf
    v_fmac_f32_dpp v90, v83, v54 quad_perm:[0,0,0,0] row_mask:0xf bank_mask:0xf
    v_fmac_f32_dpp v91, v83, v85 quad_perm:[2,2,2,2] row_mask:0xf bank_mask:0xf
    v_mov_b32 v81, v86
    v_permlane16_swap_b32 v88, v89
    v_permlane16_swap_b32 v90, v91
    v_permlane16_swap_b32 v86, v81
    v_add_f32 v88, v88, v89
    v_add_f32 v90, v90, v91
    v_add_f32 v86, v86, v81
    v_mov_b32 v81, v86
    v_permlane32_swap_b32 v88, v90
    v_add_f32 v88, v88, v90
    v_permlane32_swap_b32 v86, v81
    v_add_f32 v86, v86, v81
    v_add_f32_dpp v88, v88, v88 row_ror:4 row_mask:0xf bank_mask:0xf
    s_nop 0
    v_add_f32_dpp v86, v86, v86 row_ror:4 row_mask:0xf bank_mask:0xf
    v_add_f32_dpp v88, v88, v88 row_ror:8 row_mask:0xf bank_mask:0xf
    s_nop 0
    v_add_f32_dpp v86, v86, v86 row_ror:8 row_mask:0xf bank_mask:0xf
    v_rcp_f32 v81, v86
    s_nop 0
    v_fma_f32 v80, -v86, v81, 1.0
    v_fma_f32 v81, v80, v81, v81
    s_nop 1
    v_mul_f32_dpp v88, v81, v88 quad_perm:[1,1,1,1] row_mask:0x5 bank_mask:0xf
    v_mul_f32_dpp v88, v81, v88 quad_perm:[3,3,3,3] row_mask:0xa bank_mask:0xf
    s_mov_b32 exec_lo, 0x000f000f
    s_mov_b32 exec_hi, 0x000f000f
    v_cvt_pk_bf16_f32 v88, v88, v88
    buffer_store_short v88, v155, s[36:39], s88 offen
L_end:
L_exit:
    s_endpgm
L_sched:
    v_mov_b32 v4, 0
    v_mov_b32 v5, 0
    v_lshlrev_b32 v2, 2, v1
    v_lshlrev_b32 v3, 3, v1
    ds_write_b64 v3, v[4:5] offset:1024
    ds_write_b32 v2, v4 offset:1536
    v_lshlrev_b32 v3, 4, v1
    v_mov_b32 v8, -1
    v_mov_b32 v9, -1
    v_mov_b32 v10, -1
    v_mov_b32 v11, -1
    s_lshl_b32 s63, s2, 11
    s_lshr_b32 s89, s2, 4
    s_lshl_b32 s89, s89, 8
    s_add_u32 s89, s89, 2097152
    s_lshr_b32 s90, s56, 4
    s_lshl_b32 s59, s55, 5
    s_waitcnt lgkmcnt(0)
    s_load_dword s48, s[12:13], 0
    s_mov_b32 s44, s10
    s_and_b32 s45, s11, 0xffff
    s_mov_b32 s46, 0x4000
    s_mov_b32 s47, 0x20000
    v_lshlrev_b32 v24, 7, v1
    s_lshl_b32 s58, s56, 2
    s_add_u32 s53, s58, 0x2000
    buffer_load_dword v22, v24, s[44:47], s58 offen
    buffer_load_dword v23, v24, s[44:47], s53 offen
    s_mov_b32 s32, s18
    s_and_b32 s33, s19, 0xffff
    s_mov_b32 s34, 0x240000
    s_mov_b32 s35, 0x20000
    buffer_store_dwordx4 v[8:11], v3, s[32:35], s63 offen offset:0 sc1
    buffer_store_dwordx4 v[8:11], v3, s[32:35], s63 offen offset:1024 sc1
    s_mov_b64 exec, 1
    s_and_b32 s58, s56, 15
    s_cbranch_scc1 L_s_nozero
    buffer_store_dword v4, v4, s[32:35], s89 offen sc1
    L_s_nozero:
    s_mov_b64 exec, -1
    s_barrier
    s_mov_b32 s40, s16
    s_and_b32 s41, s17, 0xffff
    s_mov_b32 s42, 0x100
    s_mov_b32 s43, 0x20000
    s_waitcnt lgkmcnt(0)
    s_min_i32 s58, s48, 0x10000
    s_add_i32 s49, s58, 15
    s_lshr_b32 s49, s49, 4
    s_cmp_lt_i32 s48, 1
    s_cselect_b32 s49, 0x1000, s49
    s_cselect_b32 s48, 0, s58
    s_lshr_b32 s50, s49, 5
    s_sub_i32 s50, s50, 4
    s_max_i32 s50, s50, 0
    v_lshlrev_b32 v28, 1, v1
    v_mov_b32 v29, 0x10001
    v_mov_b32 v31, 0x3ff
    s_sub_i32 s58, s50, 64
    s_mov_b32 s53, 0
    s_mov_b32 s87, 3072
    s_waitcnt vmcnt(2)
    s_cmp_gt_i32 s58, 0
    s_cbranch_scc1 L_s_sort
    L_s_first:
    v_mov_b32 v23, v22
    s_mov_b32 s58, s50
    s_mov_b32 s53, 4
    s_mov_b32 s87, 2816
    L_s_sort:
    v_bfe_u32 v25, v23, 3, 10
    v_cmp_gt_i32 vcc, s58, v1
    v_add_u32 v25, 1, v25
    v_min_u32 v25, 0x3fe, v25
    v_cndmask_b32 v25, v31, v25, vcc
    v_cmp_le_i32 vcc, s53, v1
    v_mov_b32 v27, 0
    v_mov_b32 v30, 0
    v_cndmask_b32 v25, 0, v25, vcc
    v_lshl_or_b32 v25, v25, 6, v1
    ds_write_b16 v28, v25 offset:3328
    v_lshl_or_b32 v26, v25, 16, v25
    s_mov_b32 s51, 0
    L_s_half:
    ds_read_b128 v[32:35], v30 offset:3328
    ds_read_b128 v[36:39], v30 offset:3344
    ds_read_b128 v[40:43], v30 offset:3360
    ds_read_b128 v[44:47], v30 offset:3376
    v_add_u32 v30, 64, v30
    s_waitcnt lgkmcnt(3)
    v_pk_sub_u16 v32, v26, v32 clamp
    v_pk_sub_u16 v33, v26, v33 clamp
    v_pk_sub_u16 v34, v26, v34 clamp
    v_pk_sub_u16 v35, v26, v35 clamp
    s_waitcnt lgkmcnt(2)
    v_pk_sub_u16 v36, v26, v36 clamp
    v_pk_sub_u16 v37, v26, v37 clamp
    v_pk_sub_u16 v38, v26, v38 clamp
    v_pk_sub_u16 v39, v26, v39 clamp
    s_waitcnt lgkmcnt(1)
    v_pk_sub_u16 v40, v26, v40 clamp
    v_pk_sub_u16 v41, v26, v41 clamp
    v_pk_sub_u16 v42, v26, v42 clamp
    v_pk_sub_u16 v43, v26, v43 clamp
    s_waitcnt lgkmcnt(0)
    v_pk_sub_u16 v44, v26, v44 clamp
    v_pk_sub_u16 v45, v26, v45 clamp
    v_pk_sub_u16 v46, v26, v46 clamp
    v_pk_sub_u16 v47, v26, v47 clamp
    v_pk_min_u16 v32, v32, v29
    v_pk_min_u16 v33, v33, v29
    v_pk_min_u16 v34, v34, v29
    v_pk_min_u16 v35, v35, v29
    v_pk_min_u16 v36, v36, v29
    v_pk_min_u16 v37, v37, v29
    v_pk_min_u16 v38, v38, v29
    v_pk_min_u16 v39, v39, v29
    v_pk_min_u16 v40, v40, v29
    v_pk_min_u16 v41, v41, v29
    v_pk_min_u16 v42, v42, v29
    v_pk_min_u16 v43, v43, v29
    v_pk_min_u16 v44, v44, v29
    v_pk_min_u16 v45, v45, v29
    v_pk_min_u16 v46, v46, v29
    v_pk_min_u16 v47, v47, v29
    v_add3_u32 v27, v27, v32, v33
    v_add3_u32 v27, v27, v34, v35
    v_add3_u32 v27, v27, v36, v37
    v_add3_u32 v27, v27, v38, v39
    v_add3_u32 v27, v27, v40, v41
    v_add3_u32 v27, v27, v42, v43
    v_add3_u32 v27, v27, v44, v45
    v_add3_u32 v27, v27, v46, v47
    s_add_u32 s51, s51, 1
    s_cmp_lt_u32 s51, 2
    s_cbranch_scc1 L_s_half
    v_lshrrev_b32 v26, 16, v27
    v_and_b32 v27, 0xffff, v27
    v_add_lshl_u32 v27, v27, v26, 2
    v_add_u32 v27, s87, v27
    ds_write_b32 v27, v23
    s_cmp_eq_u32 s53, 0
    s_cbranch_scc1 L_s_first
    v_mov_b32 v6, 1
    ds_write_b32 v4, v6 offset:1664
    s_lshl_b32 s58, s50, 5
    s_sub_u32 s88, s49, s58
    s_lshl_b32 s58, s58, 2
    buffer_load_dword v12, v2, s[44:47], s58 offen offset:0
    buffer_load_dword v13, v2, s[44:47], s58 offen offset:256
    buffer_load_dword v14, v2, s[44:47], s58 offen offset:512
    v_mov_b32 v6, 1
    s_waitcnt vmcnt(0)
    s_mov_b64 exec, 1
    buffer_atomic_add v6, v4, s[40:43], s59 offen
    s_mov_b64 exec, -1
    ds_write_b32 v2, v12 offset:1792
    ds_write_b32 v2, v13 offset:2048
    ds_write_b32 v2, v14 offset:2304
    s_mov_b64 exec, 1
    s_mov_b32 s51, s50
    s_lshl_b32 s62, s51, 1
    s_sub_i32 s62, s62, 8
    s_sub_i32 s59, s62, 8
    L_s_far:
    ds_read_b32 v7, v4 offset:0
    s_waitcnt lgkmcnt(0)
    v_readfirstlane_b32 s61, v7
    s_cmp_ge_i32 s61, s59
    s_cbranch_scc1 L_s_near
    s_sleep 8
    s_branch L_s_far
    L_s_near:
    s_lshl_b32 s59, s55, 5
    s_mov_b32 s53, 0x40000
    L_s_cnt:
    buffer_load_dword v7, v4, s[40:43], s59 offen sc1
    s_waitcnt vmcnt(0)
    v_readfirstlane_b32 s58, v7
    s_sub_u32 s53, s53, 1
    s_cbranch_scc1 L_s_again
    s_cmp_lt_u32 s58, 32
    s_cbranch_scc1 L_s_cnt
    L_s_again:
    s_cmp_ge_i32 s61, s62
    s_cbranch_scc1 L_s_go
    ds_read_b32 v7, v4 offset:0
    s_waitcnt lgkmcnt(0)
    v_readfirstlane_b32 s61, v7
    s_branch L_s_again
    L_s_go:
    s_add_i32 s62, s62, 2
    v_mov_b32 v20, 1
    buffer_atomic_add v20, v4, s[32:35], s89 offen sc0
        L_s_p0:
    s_cmp_ge_i32 s61, s62
    s_cbranch_scc1 L_s_two0
    ds_read_b32 v7, v4 offset:0
    s_getreg_b32 s58, hwreg(HW_REG_IB_STS, 0, 4)
    s_waitcnt lgkmcnt(0)
    v_readfirstlane_b32 s61, v7
    s_cmp_lg_u32 s58, 0
    s_cbranch_scc1 L_s_p0
    s_waitcnt vmcnt(0)
    v_readfirstlane_b32 s58, v20
    s_min_u32 s58, s58, 0x10000
    s_lshl_b32 s58, s58, 1
    s_add_u32 s58, s58, s90
    s_add_u32 s53, s58, 32
    s_cmp_ge_u32 s58, s88
    s_cbranch_scc1 L_s_fin
    s_lshl_b32 s59, s58, 2
    v_mov_b32 v12, s59
    ds_read_b32 v13, v12 offset:1792
    s_add_u32 s58, s58, 1
    s_cmp_eq_u32 s58, s88
    s_cselect_b32 s58, 0x8000, 0
    s_and_b32 s59, s51, 15
    s_lshl_b32 s59, s59, 2
    s_add_u32 s51, s51, 1
    s_or_b32 s58, s58, s51
    v_mov_b32 v12, s59
    s_waitcnt lgkmcnt(0)
    v_lshl_or_b32 v13, v13, 16, s58
    ds_write_b32 v12, v13 offset:1536
    s_cmp_ge_u32 s53, s88
    s_cbranch_scc1 L_s_fin
    s_branch L_s_again
        L_s_two0:
    s_add_i32 s62, s62, 2
    v_mov_b32 v21, 1
    buffer_atomic_add v21, v4, s[32:35], s89 offen sc0
    s_waitcnt vmcnt(1)
    v_readfirstlane_b32 s58, v20
    s_min_u32 s58, s58, 0x10000
    s_lshl_b32 s58, s58, 1
    s_add_u32 s58, s58, s90
    s_add_u32 s53, s58, 32
    s_cmp_ge_u32 s58, s88
    s_cbranch_scc1 L_s_end0
    s_lshl_b32 s59, s58, 2
    v_mov_b32 v12, s59
    ds_read_b32 v13, v12 offset:1792
    s_add_u32 s58, s58, 1
    s_cmp_eq_u32 s58, s88
    s_cselect_b32 s58, 0x8000, 0
    s_and_b32 s59, s51, 15
    s_lshl_b32 s59, s59, 2
    s_add_u32 s51, s51, 1
    s_or_b32 s58, s58, s51
    v_mov_b32 v12, s59
    s_waitcnt lgkmcnt(0)
    v_lshl_or_b32 v13, v13, 16, s58
    ds_write_b32 v12, v13 offset:1536
    s_cmp_ge_u32 s53, s88
    s_cbranch_scc1 L_s_end0
        L_s_p1:
    s_cmp_ge_i32 s61, s62
    s_cbranch_scc1 L_s_two1
    ds_read_b32 v7, v4 offset:0
    s_getreg_b32 s58, hwreg(HW_REG_IB_STS, 0, 4)
    s_waitcnt lgkmcnt(0)
    v_readfirstlane_b32 s61, v7
    s_cmp_lg_u32 s58, 0
    s_cbranch_scc1 L_s_p1
    s_waitcnt vmcnt(0)
    v_readfirstlane_b32 s58, v21
    s_min_u32 s58, s58, 0x10000
    s_lshl_b32 s58, s58, 1
    s_add_u32 s58, s58, s90
    s_add_u32 s53, s58, 32
    s_cmp_ge_u32 s58, s88
    s_cbranch_scc1 L_s_fin
    s_lshl_b32 s59, s58, 2
    v_mov_b32 v12, s59
    ds_read_b32 v13, v12 offset:1792
    s_add_u32 s58, s58, 1
    s_cmp_eq_u32 s58, s88
    s_cselect_b32 s58, 0x8000, 0
    s_and_b32 s59, s51, 15
    s_lshl_b32 s59, s59, 2
    s_add_u32 s51, s51, 1
    s_or_b32 s58, s58, s51
    v_mov_b32 v12, s59
    s_waitcnt lgkmcnt(0)
    v_lshl_or_b32 v13, v13, 16, s58
    ds_write_b32 v12, v13 offset:1536
    s_cmp_ge_u32 s53, s88
    s_cbranch_scc1 L_s_fin
    s_branch L_s_again
        L_s_two1:
    s_add_i32 s62, s62, 2
    v_mov_b32 v20, 1
    buffer_atomic_add v20, v4, s[32:35], s89 offen sc0
    s_waitcnt vmcnt(1)
    v_readfirstlane_b32 s58, v21
    s_min_u32 s58, s58, 0x10000
    s_lshl_b32 s58, s58, 1
    s_add_u32 s58, s58, s90
    s_add_u32 s53, s58, 32
    s_cmp_ge_u32 s58, s88
    s_cbranch_scc1 L_s_end1
    s_lshl_b32 s59, s58, 2
    v_mov_b32 v12, s59
    ds_read_b32 v13, v12 offset:1792
    s_add_u32 s58, s58, 1
    s_cmp_eq_u32 s58, s88
    s_cselect_b32 s58, 0x8000, 0
    s_and_b32 s59, s51, 15
    s_lshl_b32 s59, s59, 2
    s_add_u32 s51, s51, 1
    s_or_b32 s58, s58, s51
    v_mov_b32 v12, s59
    s_waitcnt lgkmcnt(0)
    v_lshl_or_b32 v13, v13, 16, s58
    ds_write_b32 v12, v13 offset:1536
    s_cmp_ge_u32 s53, s88
    s_cbranch_scc1 L_s_end1
    s_branch L_s_p0
    L_s_end0:
    s_waitcnt vmcnt(0)
    v_mov_b32 v20, v21
    L_s_end1:
    s_waitcnt vmcnt(0)
    v_readfirstlane_b32 s58, v20
    s_min_u32 s58, s58, 0x10000
    s_lshl_b32 s58, s58, 1
    s_add_u32 s58, s58, s90
    s_add_u32 s53, s58, 32
    s_cmp_ge_u32 s58, s88
    s_cbranch_scc1 L_s_fin
    s_lshl_b32 s59, s58, 2
    v_mov_b32 v12, s59
    ds_read_b32 v13, v12 offset:1792
    s_add_u32 s58, s58, 1
    s_cmp_eq_u32 s58, s88
    s_cselect_b32 s58, 0x8000, 0
    s_and_b32 s59, s51, 15
    s_lshl_b32 s59, s59, 2
    s_add_u32 s51, s51, 1
    s_or_b32 s58, s58, s51
    v_mov_b32 v12, s59
    s_waitcnt lgkmcnt(0)
    v_lshl_or_b32 v13, v13, 16, s58
    ds_write_b32 v12, v13 offset:1536
    s_cmp_ge_u32 s53, s88
    L_s_fin:
    s_and_b32 s59, s51, 15
    s_lshl_b32 s59, s59, 2
    s_add_u32 s51, s51, 1
    s_or_b32 s58, s51, 0x4000
    v_mov_b32 v12, s59
    v_mov_b32 v13, s58
    ds_write_b32 v12, v13 offset:1536
    s_branch L_end
.section .rodata,"a"
.p2align 6
.amdhsa_kernel standalone__paged_block_table_kv_pagedattention__decode_kernel
  .amdhsa_next_free_vgpr 158
  .amdhsa_next_free_sgpr 102
  .amdhsa_accum_offset 160
  .amdhsa_group_segment_fixed_size 0
  .amdhsa_kernarg_size 64
  .amdhsa_user_sgpr_count 2
  .amdhsa_user_sgpr_kernarg_segment_ptr 1
  .amdhsa_system_sgpr_workgroup_id_x 1
.end_amdhsa_kernel
```
